```python
import torch

def _softmax(x, axis=-1):
    return torch.softmax(x, dim=axis)
def _gelu(x):
    return torch.nn.functional.gelu(x, approximate="tanh")
def _silu(x):
    return torch.nn.functional.silu(x)
def _sigmoid(x):
    return torch.sigmoid(x)
def _layernorm(x, axis=-1, eps=1e-5):
    m = x.mean(dim=axis, keepdim=True)
    v = x.var(dim=axis, keepdim=True, unbiased=False)
    return (x - m) / torch.sqrt(v + eps)
def _scatter_add(tgt, idx, src, axis=0):
    return tgt.clone().index_add_(axis, idx, src)
def _segment_sum(src, seg, n):
    out = torch.zeros((n,) + src.shape[1:], dtype=src.dtype)
    return out.index_add_(0, seg, src)
def _pad(x, pw):
    flat = tuple(v for pair in reversed(pw) for v in pair)
    return torch.nn.functional.pad(x, flat)

kernel_name = 'parallel_sum__sliding_block_cached__dense_activation_relu__decode'

def setup_inputs():

    _w = (lambda a: (lambda t: t.to(torch.bfloat16) if t.is_floating_point() else t)(torch.as_tensor(a)))
    def _A_setup():
        B, Sq, D = 2, 1, 512
        Hq, Hkv, Sk, Dh = 32, 8, 32768, 128
        assert Hq % Hkv == 0, (Hq, Hkv)
        return {
            "x": _w((lambda *s: torch.randn(*s, dtype=torch.bfloat16) * 0.05)(B, Sq, D)),
            "k_cache": _w((lambda *s: torch.randn(*s, dtype=torch.bfloat16) * 3.2)(B, Hkv, Sk, Dh)),
            "v_cache": _w((lambda *s: torch.randn(*s, dtype=torch.bfloat16) * 1.6)(B, Hkv, Sk, Dh)),
            "wq": _w((lambda *s: torch.randn(*s, dtype=torch.bfloat16) * 3.2)(D, Hq * Dh) * (D ** -0.5)),
            "wo": _w((lambda *s: torch.randn(*s, dtype=torch.bfloat16) * 1.6)(Hq * Dh, D) * ((Hq * Dh) ** -0.5)),
        }
    _A_in = _A_setup()

    def _B_setup():
        B, S, D, Dff = 2, 1, 512, 1792
        return {
            "x": _w((lambda *s: torch.randn(*s, dtype=torch.bfloat16) * 0.05)(B, S, D)),
            "w1": _w((lambda *s: torch.randn(*s, dtype=torch.bfloat16) * 0.05)(D, Dff)),
            "w2": _w((lambda *s: torch.randn(*s, dtype=torch.bfloat16) * 0.05)(Dff, D)),
        }
    _B_in = _B_setup()

    return {
        "A_x": _A_in["x"],
        "A_k_cache": _A_in["k_cache"],
        "A_v_cache": _A_in["v_cache"],
        "A_wq": _A_in["wq"],
        "A_wo": _A_in["wo"],
        "B_x": _B_in["x"],
        "B_w1": _B_in["w1"],
        "B_w2": _B_in["w2"],
    }

def reference(A_x, A_k_cache, A_v_cache, A_wq, A_wo, B_x, B_w1, B_w2):
    def _A_ref(x, k_cache, v_cache, wq, wo):
        B, Sq, D = x.shape
        Hq, Dh = 32, 128
        Hkv, Sk = k_cache.shape[1], k_cache.shape[2]
        W = min(4096, max(256, Sk // 4))
        rep = Hq // Hkv
        q = (lambda x, *d: x.permute(*d))((x @ wq).reshape(B, Sq, Hq, Dh), 0, 2, 1, 3)
        k = (lambda x, n, axis: torch.repeat_interleave(x, n, dim=axis))(k_cache[:, :, Sk - W:, :], rep, axis=1)
        v = (lambda x, n, axis: torch.repeat_interleave(x, n, dim=axis))(v_cache[:, :, Sk - W:, :], rep, axis=1)
        scores = torch.einsum("bhqd,bhkd->bhqk", q, k) * (Dh ** -0.5)
        p = _softmax(scores, axis=-1)
        o = torch.einsum("bhqk,bhkd->bhqd", p, v)
        return (lambda x, *d: x.permute(*d))(o, 0, 2, 1, 3).reshape(B, Sq, Hq * Dh) @ wo

    def _B_ref(x, w1, w2):
        h = torch.einsum("bsd,df->bsf", x, w1)
        zero = torch.zeros_like(h)
        h = torch.maximum(h, zero)
        return torch.einsum("bsf,fd->bsd", h, w2)

    x = A_x
    xn = _layernorm(x, axis=-1)
    return x + _A_ref(xn, A_k_cache, A_v_cache, A_wq, A_wo) + _B_ref(xn, B_w1, B_w2)
```

```asm
; @launch grid=(256,1,1) block=(640,1,1) lds=85248
.amdgcn_target "amdgcn-amd-amdhsa--gfx950"
.text
.globl parallel_sum__sliding_block_cached__dense_activation_relu__decode_kernel
.p2align 8
.type parallel_sum__sliding_block_cached__dense_activation_relu__decode_kernel,@function
parallel_sum__sliding_block_cached__dense_activation_relu__decode_kernel:
    s_cmp_ge_u32 s2, 256
    s_cbranch_scc1 L_end
    s_load_dwordx16 s[4:19], s[0:1], 0
    s_load_dwordx2 s[20:21], s[0:1], 64
    s_load_dwordx2 s[22:23], s[0:1], 80
    v_lshrrev_b32 v12, 6, v0
    v_and_b32 v1, 63, v0
    s_cmp_lt_u32 s2, 248
    s_cbranch_scc1 L_nopf
    s_getpc_b64 s[56:57]
    v_lshlrev_b32 v13, 7, v0
    v_min_u32 v13, L_end-parallel_sum__sliding_block_cached__dense_activation_relu__decode_kernel-64, v13
    global_load_dword v0, v13, s[56:57]
L_nopf:
    v_readfirstlane_b32 s24, v12
    s_and_b32 s25, s2, 7
    s_lshr_b32 s26, s2, 3
    v_lshrrev_b32 v2, 4, v1
    v_and_b32 v3, 15, v1
    s_cmp_lg_u32 s24, 0
    s_cbranch_scc1 L_notA
    s_lshr_b32 s34, s26, 3
    s_and_b32 s35, s26, 7
    s_lshl_b32 s43, s25, 3
    s_add_u32 s35, s35, s43
    s_mov_b32 s28, 65536
    s_mov_b32 s39, 0
L_w:
    s_setprio 3
    s_lshl_b32 s42, s34, 4
    v_lshrrev_b32 v12, 3, v1
    s_mul_i32 s42, s42, s28
    v_mul_lo_u32 v32, v12, s28
    s_lshl_b32 s43, s35, 7
    v_bfe_u32 v12, v1, 1, 2
    s_add_u32 s42, s42, s43
    v_lshrrev_b32 v32, 3, v32
    v_xor_b32 v12, v12, v2
    v_lshl_add_u32 v32, v12, 5, v32
    v_and_b32 v12, 1, v1
    v_lshl_add_u32 v32, v12, 4, v32
    v_add_u32 v32, s42, v32
    s_mov_b32 m0, s39
    s_cmp_eq_u32 s24, 0
    s_waitcnt lgkmcnt(0)
    s_cselect_b32 s30, s10, s16
    s_cselect_b32 s31, s11, s17
    global_load_lds_dwordx4 v32, s[30:31] nt
    s_sub_u32 s42, s28, 1024
    v_add_u32 v33, s42, v32
    v_add_u32 v34, s42, v33
    v_add_u32 v35, s42, v34
    s_mul_i32 s43, s28, 4
    v_lshlrev_b32 v4, 5, v1
    s_lshl_b32 s42, s34, 8
    v_and_b32 v12, 1024, v4
    v_and_b32 v13, 31, v1
    v_lshl_add_u32 v12, v13, 3, v12
    v_add_u32 v5, s42, v12
    s_add_u32 s45, s39, 16384
    global_load_dwordx4 v[80:83], v4, s[4:5]
    global_load_dwordx4 v[84:87], v4, s[4:5] offset:16
    global_load_dwordx2 v[88:89], v5, s[4:5]
    s_branch L_dma1
L_dma:
    global_load_lds_dwordx4 v32, s[30:31] offset:0 nt
L_dma1:
    global_load_lds_dwordx4 v33, s[30:31] offset:1024 nt
    global_load_lds_dwordx4 v34, s[30:31] offset:2048 nt
    global_load_lds_dwordx4 v35, s[30:31] offset:3072 nt
    s_add_u32 m0, m0, 4096
    v_add_u32 v32, s43, v32
    v_add_u32 v33, s43, v33
    v_add_u32 v34, s43, v34
    v_add_u32 v35, s43, v35
    s_cmp_lt_u32 m0, s45
    s_cbranch_scc1 L_dma
    s_barrier
    s_branch L_aux2
L_B:
    v_mov_b32 v15, 0
    ds_write_b32 v15, v15 offset:35840
    ds_write_b32 v15, v15 offset:35844
    ds_write_b32 v15, v15 offset:35848
    s_mov_b32 s24, 1
    s_lshl_b32 s41, s25, 2
    s_lshr_b32 s34, 2290627088, s41
    s_and_b32 s34, s34, 15
    s_mov_b32 s35, s26
    s_movk_i32 s28, 28672
    s_movk_i32 s39, 16384
    s_cmp_ge_u32 s26, 28
    s_cselect_b32 s34, 8, s34
    s_cmp_lt_u32 s34, 8
    s_cbranch_scc1 L_w
    s_waitcnt lgkmcnt(0)
    s_barrier
    s_endpgm
L_notA:
    s_sub_u32 s24, s24, 2
    s_cbranch_scc1 L_B
    s_setprio 2
    s_and_b32 s27, s26, 1
    s_lshr_b32 s28, s26, 1
    s_lshl_b32 s41, s27, 26
    s_lshl_b32 s46, s25, 23
    s_add_u32 s41, s41, s46
    s_lshl_b32 s46, s28, 16
    s_add_u32 s41, s41, s46
    s_lshl_b32 s46, s24, 13
    s_add_u32 s41, s41, s46
    s_add_u32 s41, s41, 7340032
    v_lshrrev_b32 v12, 2, v3
    v_lshlrev_b32 v4, 8, v12
    v_and_b32 v12, 2, v3
    v_lshl_add_u32 v4, v12, 9, v4
    v_and_b32 v12, 1, v3
    v_lshl_add_u32 v4, v12, 6, v4
    v_lshl_add_u32 v4, v2, 4, v4
    v_add_u32 v4, s41, v4
    v_lshl_add_u32 v5, v1, 4, s41
    s_add_u32 s42, s24, s26
    s_and_b32 s42, s42, 3
    s_lshl_b32 s42, s42, 11
    v_xor_b32 v88, s42, v5
    v_xor_b32 v80, s42, v4
    v_xor_b32 v82, 2048, v80
    v_xor_b32 v84, 4096, v80
    v_xor_b32 v86, 6144, v80
    v_mov_b32 v8, 0
    v_mov_b32 v165, 1
    s_waitcnt lgkmcnt(0)
    s_barrier
    global_load_dwordx4 v[16:19], v80, s[6:7] nt
    global_load_dwordx4 v[20:23], v80, s[6:7] offset:128 nt
    s_branch L_str2
L_aux2:
    s_load_dword s33, s[22:23], 0
    s_sub_u32 s24, s24, 2
    s_and_b32 s27, s26, 1
    s_mov_b32 s38, 400000
    s_movk_i32 s36, 16384
    s_mov_b32 s41, 262144
    s_cmp_eq_u32 s24, -2
    s_cselect_b32 s36, s36, 7168
    s_cselect_b32 s41, s41, 4096
    s_lshl_b32 s35, s35, 8
    s_add_u32 s35, s35, s41
    s_mul_i32 s41, s34, s36
    s_lshl_b32 s41, s41, 1
    s_add_u32 s35, s35, s41
    s_lshr_b32 s45, s39, 5
    s_add_u32 s45, s45, 32768
    v_bfe_u32 v12, v3, 2, 1
    v_lshlrev_b32 v6, 8, v12
    v_lshl_add_u32 v6, v2, 3, v6
    v_add_u32 v6, s45, v6
    v_lshrrev_b32 v12, 2, v1
    v_lshlrev_b32 v13, 7, v12
    v_and_b32 v14, 3, v1
    v_lshl_add_u32 v13, v14, 3, v13
    v_add_u32 v13, s39, v13
    v_bfe_u32 v12, v1, 3, 2
    v_lshl_add_u32 v8, v12, 5, v13
    v_xor_b32 v9, 32, v8
    v_xor_b32 v10, 64, v8
    v_xor_b32 v11, 96, v8
    v_and_b32 v12, 1, v2
    v_mul_lo_u32 v7, v12, s36
    v_lshrrev_b32 v12, 1, v2
    v_lshl_add_u32 v7, v12, 7, v7
    v_and_b32 v12, 1, v3
    v_cmp_eq_u32 s[14:15], 1, v12
    v_lshl_add_u32 v7, v12, 6, v7
    v_and_b32 v12, 14, v3
    v_lshl_add_u32 v7, v12, 2, v7
    v_add_u32 v7, s35, v7
    v_lshl_add_u32 v15, v1, 3, s45
    s_mov_b32 s41, 1065369472
    s_waitcnt vmcnt(15)
    v_dot2_f32_bf16 v104, v80, s41, 0
    v_dot2_f32_bf16 v106, v81, s41, 0
    v_dot2_f32_bf16 v104, v82, s41, v104
    v_dot2_f32_bf16 v106, v83, s41, v106
    v_dot2_f32_bf16 v104, v84, s41, v104
    v_dot2_f32_bf16 v106, v85, s41, v106
    v_dot2_f32_bf16 v104, v86, s41, v104
    v_dot2_f32_bf16 v106, v87, s41, v106
    v_lshlrev_b32 v112, 16, v80
    v_and_b32 v113, 4294901760, v80
    v_lshlrev_b32 v114, 16, v81
    v_and_b32 v115, 4294901760, v81
    v_add_f32 v104, v104, v106
    v_lshlrev_b32 v116, 16, v82
    v_and_b32 v117, 4294901760, v82
    v_add_f32_dpp v104, v104, v104 row_ror:8 row_mask:0xf bank_mask:0xf
    v_lshlrev_b32 v118, 16, v83
    v_and_b32 v119, 4294901760, v83
    v_add_f32_dpp v104, v104, v104 row_ror:4 row_mask:0xf bank_mask:0xf
    v_lshlrev_b32 v120, 16, v84
    v_and_b32 v121, 4294901760, v84
    v_add_f32_dpp v104, v104, v104 row_ror:2 row_mask:0xf bank_mask:0xf
    v_lshlrev_b32 v122, 16, v85
    v_and_b32 v123, 4294901760, v85
    v_add_f32_dpp v104, v104, v104 row_ror:1 row_mask:0xf bank_mask:0xf
    v_mov_b32 v106, v104
    v_lshlrev_b32 v124, 16, v86
    v_and_b32 v125, 4294901760, v86
    v_permlane16_swap_b32 v104, v106
    v_lshlrev_b32 v126, 16, v87
    v_and_b32 v127, 4294901760, v87
    v_add_f32 v104, v104, v106
    v_lshlrev_b32 v92, 16, v88
    v_and_b32 v93, 4294901760, v88
    v_lshlrev_b32 v94, 16, v89
    v_and_b32 v95, 4294901760, v89
    v_mul_f32 v104, 989855744, v104
    v_sub_f32 v112, v112, v104
    v_sub_f32 v113, v113, v104
    v_sub_f32 v114, v114, v104
    v_sub_f32 v115, v115, v104
    v_sub_f32 v116, v116, v104
    v_sub_f32 v117, v117, v104
    v_sub_f32 v118, v118, v104
    v_sub_f32 v119, v119, v104
    v_sub_f32 v120, v120, v104
    v_sub_f32 v121, v121, v104
    v_sub_f32 v122, v122, v104
    v_sub_f32 v123, v123, v104
    v_sub_f32 v124, v124, v104
    v_sub_f32 v125, v125, v104
    v_sub_f32 v126, v126, v104
    v_sub_f32 v127, v127, v104
    v_mul_f32 v128, v112, v112
    v_mul_f32 v129, v113, v113
    v_mul_f32 v130, v114, v114
    v_mul_f32 v131, v115, v115
    v_fmac_f32 v128, v116, v116
    v_fmac_f32 v129, v117, v117
    v_fmac_f32 v130, v118, v118
    v_fmac_f32 v131, v119, v119
    v_fmac_f32 v128, v120, v120
    v_fmac_f32 v129, v121, v121
    v_fmac_f32 v130, v122, v122
    v_fmac_f32 v131, v123, v123
    v_fmac_f32 v128, v124, v124
    v_fmac_f32 v129, v125, v125
    v_fmac_f32 v130, v126, v126
    v_fmac_f32 v131, v127, v127
    v_add_f32 v128, v128, v129
    v_add_f32 v130, v130, v131
    v_add_f32 v105, v128, v130
    s_nop 1
    v_add_f32_dpp v105, v105, v105 row_ror:8 row_mask:0xf bank_mask:0xf
    s_nop 1
    v_add_f32_dpp v105, v105, v105 row_ror:4 row_mask:0xf bank_mask:0xf
    s_nop 1
    v_add_f32_dpp v105, v105, v105 row_ror:2 row_mask:0xf bank_mask:0xf
    s_nop 1
    v_add_f32_dpp v105, v105, v105 row_ror:1 row_mask:0xf bank_mask:0xf
    v_mov_b32 v107, v105
    s_nop 1
    v_permlane16_swap_b32 v105, v107
    v_add_f32 v105, v105, v107
    v_mul_f32 v105, 989855744, v105
    v_cvt_pk_bf16_f32 v110, v104, v105
    v_and_b32 v105, 4294901760, v110
    v_lshlrev_b32 v104, 16, v110
    v_add_f32 v105, 925353388, v105
    v_sub_f32 v92, v92, v104
    v_sub_f32 v93, v93, v104
    v_cvt_pk_bf16_f32 v105, v105, v105
    v_lshlrev_b32 v105, 16, v105
    v_sqrt_f32 v105, v105
    v_sub_f32 v94, v94, v104
    v_sub_f32 v95, v95, v104
    v_cvt_pk_bf16_f32 v105, v105, v105
    v_cvt_pk_bf16_f32 v88, v92, v93
    v_cvt_pk_bf16_f32 v89, v94, v95
    v_lshlrev_b32 v105, 16, v105
    v_rcp_f32 v105, v105
    v_lshlrev_b32 v92, 16, v88
    v_and_b32 v93, 4294901760, v88
    v_lshlrev_b32 v94, 16, v89
    v_and_b32 v95, 4294901760, v89
    v_mul_f32 v92, v92, v105
    v_mul_f32 v93, v93, v105
    v_mul_f32 v94, v94, v105
    v_mul_f32 v95, v95, v105
    v_cvt_pk_bf16_f32 v88, v92, v93
    v_cvt_pk_bf16_f32 v89, v94, v95
    ds_write_b64 v15, v[88:89]
    v_cmp_gt_u32 vcc, 32, v1
    s_waitcnt lgkmcnt(0)
    s_add_u32 s32, s33, 1799596469
    s_movk_i32 s49, 255
    s_and_b32 s54, s32, 255
    s_getreg_b32 s41, hwreg(HW_REG_XCC_ID, 0, 3)
    s_xor_b32 s53, s54, s41
    s_cmp_eq_u32 s24, -2
    s_cselect_b32 s41, s53, s54
    v_mov_b32 v149, s41
    s_waitcnt vmcnt(8)
    ds_read2_b64 v[32:35], v6 offset0:0 offset1:4
    ds_read_b64_tr_b16 v[48:49], v8 offset:0
    ds_read_b64_tr_b16 v[50:51], v8 offset:2048
    ds_read_b64_tr_b16 v[52:53], v9 offset:0
    ds_read_b64_tr_b16 v[54:55], v9 offset:2048
    ds_read_b64_tr_b16 v[56:57], v10 offset:0
    ds_read_b64_tr_b16 v[58:59], v10 offset:2048
    ds_read_b64_tr_b16 v[60:61], v11 offset:0
    ds_read_b64_tr_b16 v[62:63], v11 offset:2048
    ds_read2_b64 v[36:39], v6 offset0:8 offset1:12
    ds_read_b64_tr_b16 v[64:65], v8 offset:4096
    ds_read_b64_tr_b16 v[66:67], v8 offset:6144
    ds_read_b64_tr_b16 v[68:69], v9 offset:4096
    ds_read_b64_tr_b16 v[70:71], v9 offset:6144
    ds_read_b64_tr_b16 v[72:73], v10 offset:4096
    ds_read_b64_tr_b16 v[74:75], v10 offset:6144
    ds_read_b64_tr_b16 v[76:77], v11 offset:4096
    ds_read_b64_tr_b16 v[78:79], v11 offset:6144
    s_waitcnt lgkmcnt(9)
    v_mfma_f32_16x16x32_bf16 v[16:19], v[32:35], v[48:51], 0
    v_mfma_f32_16x16x32_bf16 v[20:23], v[32:35], v[52:55], 0
    v_mfma_f32_16x16x32_bf16 v[24:27], v[32:35], v[56:59], 0
    v_mfma_f32_16x16x32_bf16 v[28:31], v[32:35], v[60:63], 0
    s_waitcnt vmcnt(0) lgkmcnt(0)
    ds_read2_b64 v[40:43], v6 offset0:16 offset1:20
    ds_read_b64_tr_b16 v[112:113], v8 offset:8192
    ds_read_b64_tr_b16 v[114:115], v8 offset:10240
    ds_read_b64_tr_b16 v[116:117], v9 offset:8192
    ds_read_b64_tr_b16 v[118:119], v9 offset:10240
    ds_read_b64_tr_b16 v[120:121], v10 offset:8192
    ds_read_b64_tr_b16 v[122:123], v10 offset:10240
    ds_read_b64_tr_b16 v[124:125], v11 offset:8192
    ds_read_b64_tr_b16 v[126:127], v11 offset:10240
    ds_read2_b64 v[44:47], v6 offset0:24 offset1:28
    ds_read_b64_tr_b16 v[128:129], v8 offset:12288
    ds_read_b64_tr_b16 v[130:131], v8 offset:14336
    ds_read_b64_tr_b16 v[132:133], v9 offset:12288
    ds_read_b64_tr_b16 v[134:135], v9 offset:14336
    ds_read_b64_tr_b16 v[136:137], v10 offset:12288
    ds_read_b64_tr_b16 v[138:139], v10 offset:14336
    ds_read_b64_tr_b16 v[140:141], v11 offset:12288
    ds_read_b64_tr_b16 v[142:143], v11 offset:14336
    v_mfma_f32_16x16x32_bf16 v[16:19], v[36:39], v[64:67], v[16:19]
    v_mfma_f32_16x16x32_bf16 v[20:23], v[36:39], v[68:71], v[20:23]
    v_mfma_f32_16x16x32_bf16 v[24:27], v[36:39], v[72:75], v[24:27]
    v_mfma_f32_16x16x32_bf16 v[28:31], v[36:39], v[76:79], v[28:31]
    s_waitcnt lgkmcnt(9)
    v_mfma_f32_16x16x32_bf16 v[16:19], v[40:43], v[112:115], v[16:19]
    v_mfma_f32_16x16x32_bf16 v[20:23], v[40:43], v[116:119], v[20:23]
    v_mfma_f32_16x16x32_bf16 v[24:27], v[40:43], v[120:123], v[24:27]
    v_mfma_f32_16x16x32_bf16 v[28:31], v[40:43], v[124:127], v[28:31]
    s_waitcnt lgkmcnt(0)
    v_mfma_f32_16x16x32_bf16 v[16:19], v[44:47], v[128:131], v[16:19]
    v_mfma_f32_16x16x32_bf16 v[20:23], v[44:47], v[132:135], v[20:23]
    v_mfma_f32_16x16x32_bf16 v[24:27], v[44:47], v[136:139], v[24:27]
    v_mfma_f32_16x16x32_bf16 v[28:31], v[44:47], v[140:143], v[28:31]
    s_nop 6
    v_cndmask_b32 v82, v24, v16, vcc
    v_cndmask_b32 v83, v28, v20, vcc
    v_cndmask_b32 v84, v83, v82, s[14:15]
    v_cndmask_b32 v85, v82, v83, s[14:15]
    s_nop 0
    v_mov_b32_dpp v84, v84 quad_perm:[1,0,3,2] row_mask:0xf bank_mask:0xf
    v_add_u32 v85, 128, v85
    v_add_u32 v84, 128, v84
    v_bfi_b32 v85, s49, v149, v85
    v_bfi_b32 v84, s49, v149, v84
    v_cndmask_b32 v80, v85, v84, s[14:15]
    v_cndmask_b32 v81, v84, v85, s[14:15]
    s_cmp_eq_u32 s24, -2
    s_cbranch_scc0 L_bpub
    global_store_dwordx2 v7, v[80:81], s[22:23]
    v_mov_b32 v13, 0
    v_lshlrev_b32 v14, 2, v1
    ds_write_b32 v14, v13 offset:33792
    s_branch L_bdone
L_bpub:
    global_store_dwordx2 v7, v[80:81], s[22:23] sc1
    s_branch L_auxend
L_bdone:
    s_lshl_b32 s45, s27, 14
    s_lshl_b32 s46, s25, 11
    s_add_u32 s45, s45, s46
    s_add_u32 s45, s45, 262144
    v_lshl_add_u32 v8, v1, 4, s45
    v_add_u32 v9, 32768, v8
    v_add_u32 v10, 65536, v8
    v_add_u32 v11, 98304, v8
    v_lshlrev_b32 v4, 3, v1
    s_mov_b32 s45, 100000
L_mark:
    ds_read_b32 v12, v13 offset:35844
    s_waitcnt lgkmcnt(0)
    v_cmp_gt_u32 vcc, 896, v12
    s_cbranch_vccz L_marked
    s_sleep 1
    s_sub_u32 s45, s45, 1
    s_cbranch_scc0 L_mark
L_marked:
    s_mov_b32 s42, 1
    s_mov_b32 s45, 3
    s_xor_b32 s43, s53, s54
    s_mov_b32 s30, s53
    s_xor_b32 s31, s43, 90
    s_and_b32 s44, s32, 65280
    s_lshl_b32 s44, s44, 9
    s_xor_b32 s44, s44, 33816576
L_qpoll:
    s_sub_i32 s45, s45, 1
    s_cmp_ge_i32 s45, 0
    s_cbranch_scc1 L_qsame
    s_cmp_lg_i32 s45, -1
    s_cbranch_scc1 L_qalt
    s_mov_b64 s[56:57], exec
    s_mov_b64 exec, -1
    v_xor_b32 v82, s43, v80
    v_xor_b32 v83, s31, v81
    v_xor_b32 v7, s44, v7
    global_store_dwordx2 v7, v[82:83], s[22:23] sc1
    s_mov_b32 s42, 5
    s_mov_b64 exec, s[56:57]
L_qalt:
    s_xor_b32 s53, s53, s43
    s_xor_b32 s30, s30, s31
    v_xor_b32 v8, s44, v8
    v_xor_b32 v9, s44, v9
    v_xor_b32 v10, s44, v10
    v_xor_b32 v11, s44, v11
L_qsame:
    global_load_dwordx4 v[96:99], v8, s[22:23] offset:0 sc1
    global_load_dwordx4 v[100:103], v8, s[22:23] offset:1024 sc1
    global_load_dwordx4 v[104:107], v9, s[22:23] offset:0 sc1
    global_load_dwordx4 v[108:111], v9, s[22:23] offset:1024 sc1
    global_load_dwordx4 v[112:115], v10, s[22:23] offset:0 sc1
    global_load_dwordx4 v[116:119], v10, s[22:23] offset:1024 sc1
    global_load_dwordx4 v[120:123], v11, s[22:23] offset:0 sc1
    global_load_dwordx4 v[124:127], v11, s[22:23] offset:1024 sc1
    s_waitcnt vmcnt(0)
    v_xor_b32 v96, s53, v96
    v_xor_b32 v97, s30, v97
    v_xor_b32 v98, s53, v98
    v_xor_b32 v99, s30, v99
    v_xor_b32 v100, s53, v100
    v_xor_b32 v101, s30, v101
    v_xor_b32 v102, s53, v102
    v_xor_b32 v103, s30, v103
    v_xor_b32 v104, s53, v104
    v_xor_b32 v105, s30, v105
    v_xor_b32 v106, s53, v106
    v_xor_b32 v107, s30, v107
    v_xor_b32 v108, s53, v108
    v_xor_b32 v109, s30, v109
    v_xor_b32 v110, s53, v110
    v_xor_b32 v111, s30, v111
    v_xor_b32 v112, s53, v112
    v_xor_b32 v113, s30, v113
    v_xor_b32 v114, s53, v114
    v_xor_b32 v115, s30, v115
    v_xor_b32 v116, s53, v116
    v_xor_b32 v117, s30, v117
    v_xor_b32 v118, s53, v118
    v_xor_b32 v119, s30, v119
    v_xor_b32 v120, s53, v120
    v_xor_b32 v121, s30, v121
    v_xor_b32 v122, s53, v122
    v_xor_b32 v123, s30, v123
    v_xor_b32 v124, s53, v124
    v_xor_b32 v125, s30, v125
    v_xor_b32 v126, s53, v126
    v_xor_b32 v127, s30, v127
    v_or3_b32 v14, v96, v97, v98
    v_or3_b32 v15, v99, v100, v101
    v_or3_b32 v14, v14, v102, v103
    v_or3_b32 v15, v15, v104, v105
    v_or3_b32 v14, v14, v106, v107
    v_or3_b32 v15, v15, v108, v109
    v_or3_b32 v14, v14, v110, v111
    v_or3_b32 v15, v15, v112, v113
    v_or3_b32 v14, v14, v114, v115
    v_or3_b32 v15, v15, v116, v117
    v_or3_b32 v14, v14, v118, v119
    v_or3_b32 v15, v15, v120, v121
    v_or3_b32 v14, v14, v122, v123
    v_or3_b32 v15, v15, v124, v125
    v_or3_b32 v14, v14, v126, v127
    v_or_b32 v14, v14, v15
    v_and_b32 v14, s49, v14
    v_cmp_ne_u32 vcc, 0, v14
    s_cbranch_vccz L_qok
    s_mov_b64 exec, vcc
    s_sub_u32 s38, s38, 1
    s_cbranch_scc0 L_qpoll
    s_branch L_end
L_qok:
    s_mov_b64 exec, -1
    v_add_f32 v96, v96, v104
    v_add_f32 v112, v112, v120
    v_add_f32 v97, v97, v105
    v_add_f32 v113, v113, v121
    v_add_f32 v98, v98, v106
    v_add_f32 v114, v114, v122
    v_add_f32 v99, v99, v107
    v_add_f32 v115, v115, v123
    v_add_f32 v100, v100, v108
    v_add_f32 v116, v116, v124
    v_add_f32 v101, v101, v109
    v_add_f32 v117, v117, v125
    v_add_f32 v102, v102, v110
    v_add_f32 v118, v118, v126
    v_add_f32 v103, v103, v111
    v_add_f32 v119, v119, v127
    v_add_f32 v96, v96, v112
    v_add_f32 v97, v97, v113
    v_add_f32 v98, v98, v114
    v_add_f32 v99, v99, v115
    v_add_f32 v100, v100, v116
    v_add_f32 v101, v101, v117
    v_add_f32 v102, v102, v118
    v_add_f32 v103, v103, v119
    v_cvt_pk_bf16_f32 v104, v96, v97
    v_cvt_pk_bf16_f32 v105, v98, v99
    v_cvt_pk_bf16_f32 v106, v100, v101
    v_cvt_pk_bf16_f32 v107, v102, v103
    ds_write_b64 v4, v[104:105] offset:34048
    ds_write_b64 v4, v[106:107] offset:34560
    v_mov_b32 v12, s42
    ds_write_b32 v13, v12 offset:35840
L_auxend:
    s_endpgm
L_str2:
    s_mov_b32 s38, 400000
    s_and_b32 s30, s26, 3
    s_lshr_b32 s41, s26, 2
    s_lshl_b32 s29, s25, 3
    s_add_u32 s29, s29, s41
    s_lshl_b32 s42, s25, 2
    s_lshr_b32 s40, 839944328, s42
    s_and_b32 s40, s40, 15
    s_lshl_b32 s55, s40, 3
    s_add_u32 s55, s55, s41
    s_mov_b32 s58, s40
    s_mov_b32 s59, s55
    global_load_dwordx4 v[24:27], v82, s[6:7] nt
    s_lshr_b32 s42, s29, 1
    s_and_b32 s44, s29, 1
    s_mov_b32 s34, 84148480
    s_mov_b32 s35, 117834498
    s_mov_b32 s36, 1035273459
    s_mov_b32 s37, 1069066811
    s_movk_i32 s48, 4095
    global_load_dwordx4 v[28:31], v82, s[6:7] offset:128 nt
    s_movk_i32 s49, 255
    v_lshrrev_b32 v12, 2, v3
    v_lshlrev_b32 v14, 8, v12
    s_lshl_b32 s41, s24, 3
    s_add_u32 s41, s41, 35584
    v_lshl_add_u32 v161, v12, 6, s41
    v_and_b32 v12, 1, v3
    v_cmp_eq_u32 s[56:57], 1, v12
    global_load_dwordx4 v[32:35], v84, s[6:7] nt
    v_lshl_add_u32 v14, v12, 6, v14
    v_lshl_add_u32 v14, v2, 4, v14
    v_add_u32 v14, 34048, v14
    v_and_b32 v12, 2, v3
    v_cmp_eq_u32 vcc, 0, v12
    v_mov_b32 v13, 33792
    s_nop 0
    global_load_dwordx4 v[36:39], v84, s[6:7] offset:128 nt
    v_cndmask_b32 v4, v13, v14, vcc
    v_cndmask_b32 v160, v14, v13, vcc
    v_and_b32 v15, 7, v1
    v_lshlrev_b32 v11, 6, v2
    v_lshl_add_u32 v11, v15, 3, v11
    s_lshl_b32 s41, s24, 11
    v_lshl_add_u32 v162, v1, 2, s41
    s_lshl_b32 s41, s24, 8
    global_load_dwordx4 v[40:43], v86, s[6:7] nt
    v_lshl_add_u32 v163, v1, 2, s41
    s_lshl_b32 s41, s25, 17
    s_lshl_b32 s46, s27, 14
    s_add_u32 s41, s41, s46
    s_lshl_b32 s46, s28, 10
    s_add_u32 s41, s41, s46
    s_lshl_b32 s46, s24, 7
    global_load_dwordx4 v[44:47], v86, s[6:7] offset:128 nt
    s_setprio 1
    s_add_u32 s41, s41, s46
    s_add_u32 s41, s41, 1048576
    v_lshlrev_b32 v9, 15, v2
    v_lshl_add_u32 v9, v3, 3, v9
    v_add_u32 v9, s41, v9
    s_lshr_b32 s43, s24, 2
    s_and_b32 s45, s24, 3
    s_lshl_b32 s41, s42, 15
    ds_add_u32 v8, v165 offset:35844
    global_load_dwordx4 v[48:51], v88, s[8:9] nt
    s_lshl_b32 s46, s43, 14
    s_add_u32 s41, s41, s46
    s_lshl_b32 s46, s44, 9
    s_add_u32 s41, s41, s46
    s_lshl_b32 s46, s45, 7
    s_add_u32 s41, s41, s46
    s_add_u32 s41, s41, 1048576
    v_xor_b32 v89, 4096, v88
    global_load_dwordx4 v[52:55], v89, s[8:9] nt
    v_lshrrev_b32 v12, 3, v1
    v_lshlrev_b32 v10, 11, v12
    v_lshl_add_u32 v10, v15, 4, v10
    v_add_u32 v10, s41, v10
    s_lshl_b32 s41, s24, 5
    v_lshl_add_u32 v153, v15, 2, v2
    v_add_u32 v153, s41, v153
    global_load_dwordx4 v[56:59], v88, s[8:9] offset:1024 nt
    s_and_b32 s43, s29, 7
    s_lshl_b32 s41, s30, 16
    s_lshl_b32 s46, s24, 13
    s_add_u32 s41, s41, s46
    s_lshl_b32 s46, s43, 10
    s_add_u32 s41, s41, s46
    s_lshl_b32 s46, s25, 7
    s_add_u32 s41, s41, s46
    global_load_dwordx4 v[60:63], v89, s[8:9] offset:1024 nt
    s_add_u32 s41, s41, 524288
    v_lshl_add_u32 v150, v1, 2, s41
    v_lshrrev_b32 v156, 2, v1
    v_and_b32 v13, 7, v156
    v_xor_b32 v13, s24, v13
    v_lshlrev_b32 v151, 8, v156
    v_lshl_add_u32 v151, v13, 5, v151
    ds_add_u32 v8, v165 offset:35844
    v_xor_b32 v92, 2048, v88
    global_load_dwordx4 v[64:67], v92, s[8:9] nt
    v_and_b32 v14, 3, v1
    v_lshl_add_u32 v151, v14, 3, v151
    v_add_u32 v151, 52480, v151
    v_bfe_u32 v12, v3, 2, 1
    v_lshlrev_b32 v13, 3, v2
    v_lshl_add_u32 v152, v12, 7, v13
    v_add_u32 v152, 35072, v152
    v_mul_u32_u24 v154, 14336, v14
    v_xor_b32 v93, 6144, v88
    global_load_dwordx4 v[68:71], v93, s[8:9] nt
    v_min_u32 v12, 13, v156
    v_lshl_add_u32 v154, v12, 4, v154
    s_mul_i32 s41, s55, 224
    s_add_u32 s41, s41, 7680
    v_add_u32 v154, s41, v154
    v_lshlrev_b32 v157, 3, v156
    s_and_b32 s41, s29, 1
    global_load_dwordx4 v[72:75], v92, s[8:9] offset:1024 nt
    s_lshr_b32 s42, s29, 1
    s_lshl_b32 s44, s42, 13
    s_lshl_b32 s46, s41, 6
    s_add_u32 s44, s44, s46
    s_add_u32 s44, s44, 528384
    v_lshlrev_b32 v164, 7, v3
    v_lshl_add_u32 v164, v2, 4, v164
    v_add_u32 v164, s44, v164
    global_load_dwordx4 v[76:79], v93, s[8:9] offset:1024 nt
    s_setprio 0
    ds_add_u32 v8, v165 offset:35844
    s_load_dword s33, s[22:23], 0
    s_lshl_b32 s43, s41, 10
    s_lshl_b32 s46, s42, 5
    s_add_u32 s43, s43, s46
    v_lshl_add_u32 v155, v2, 3, s43
    s_or_b32 s28, s30, s24
    s_lshr_b32 s40, s40, 3
    s_or_b32 s55, s40, s24
    v_lshrrev_b32 v12, 1, v3
    v_xor_b32 v12, v12, v2
    v_and_b32 v13, 1, v3
    v_lshlrev_b32 v13, 4, v13
    v_lshl_add_u32 v13, v12, 5, v13
    s_lshl_b32 s39, s24, 11
    s_lshr_b32 s42, s29, 1
    s_and_b32 s43, s24, 1
    s_and_b32 s44, s29, 1
    s_lshr_b32 s45, s24, 1
    s_lshl_b32 s41, s42, 17
    s_lshl_b32 s46, s43, 16
    s_add_u32 s41, s41, s46
    s_lshl_b32 s46, s44, 12
    s_add_u32 s41, s41, s46
    s_lshl_b32 s46, s45, 10
    s_add_u32 s41, s41, s46
    s_lshl_b32 s46, s30, 8
    s_add_u32 s41, s41, s46
    v_lshl_add_u32 v6, v2, 13, v13
    v_add_u32 v6, s41, v6
    v_xor_b32 v7, 128, v6
    v_add_u32 v7, 32768, v7
    s_add_u32 m0, s39, 52480
    s_nop 0
    global_load_lds_dwordx4 v6, s[12:13] nt
    s_add_u32 m0, s39, 53504
    s_nop 0
    global_load_lds_dwordx4 v7, s[12:13] nt
    s_cmp_ge_u32 s58, 8
    s_cbranch_scc1 L_now2
    s_lshl_b32 s41, s24, 3
    v_add_u32 v12, s41, v2
    v_add_u32 v14, 4, v12
    v_min_u32 v12, 55, v12
    v_min_u32 v14, 55, v14
    s_mul_i32 s41, s59, 57344
    s_lshl_b32 s43, s30, 8
    s_add_u32 s41, s41, s43
    v_lshl_add_u32 v12, v12, 10, v13
    v_lshl_add_u32 v14, v14, 10, v13
    v_xor_b32 v14, 128, v14
    v_add_u32 v12, s41, v12
    v_add_u32 v14, s41, v14
    s_add_u32 m0, s39, 68864
    s_nop 0
    global_load_lds_dwordx4 v12, s[18:19] nt
    s_add_u32 m0, s39, 69888
    s_nop 0
    global_load_lds_dwordx4 v14, s[18:19] nt
L_now2:
    v_mov_b32 v15, 0
    s_waitcnt lgkmcnt(0)
    s_add_u32 s32, s33, 1799596469
    s_and_b32 s53, s32, 4095
    s_and_b32 s54, s32, 255
    v_mov_b32 v149, s32
L_qf:
    ds_read_b32 v12, v15 offset:35840
    s_waitcnt lgkmcnt(0)
    v_readfirstlane_b32 s31, v12
    s_cmp_lg_u32 s31, 0
    s_cbranch_scc1 L_qhere
    s_sleep 1
    s_sub_u32 s38, s38, 1
    s_cbranch_scc0 L_qf
    s_branch L_end
L_qhere:
    ds_read_b128 v[112:115], v4 offset:0
    ds_read_b128 v[116:119], v160 offset:0
    ds_read_b128 v[120:123], v4 offset:128
    ds_read_b128 v[124:127], v160 offset:128
    s_waitcnt vmcnt(10) lgkmcnt(0)
    v_mfma_f32_16x16x32_bf16 v[128:131], v[16:19], v[112:115], 0
    v_mfma_f32_16x16x32_bf16 v[132:135], v[32:35], v[112:115], 0
    v_mfma_f32_16x16x32_bf16 v[128:131], v[24:27], v[116:119], v[128:131]
    v_mfma_f32_16x16x32_bf16 v[132:135], v[40:43], v[116:119], v[132:135]
    v_mfma_f32_16x16x32_bf16 v[128:131], v[20:23], v[120:123], v[128:131]
    v_mfma_f32_16x16x32_bf16 v[132:135], v[36:39], v[120:123], v[132:135]
    v_mfma_f32_16x16x32_bf16 v[128:131], v[28:31], v[124:127], v[128:131]
    v_mfma_f32_16x16x32_bf16 v[132:135], v[44:47], v[124:127], v[132:135]
    s_nop 6
    v_cndmask_b32 v114, v130, v129, s[56:57]
    v_cndmask_b32 v112, v128, v131, s[56:57]
    v_cndmask_b32 v115, v134, v133, s[56:57]
    v_cndmask_b32 v113, v132, v135, s[56:57]
    v_add_f32_dpp v112, v114, v112 quad_perm:[1,0,3,2] row_mask:0xf bank_mask:0xf
    s_nop 0
    v_add_f32_dpp v113, v115, v113 quad_perm:[1,0,3,2] row_mask:0xf bank_mask:0xf
    v_cvt_pk_bf16_f32 v12, v112, v113
    v_lshlrev_b32 v112, 16, v12
    v_and_b32 v113, 4294901760, v12
    v_mul_f32 v112, s36, v112
    v_mul_f32 v113, s36, v113
    v_cvt_pk_bf16_f32 v12, v112, v113
    v_lshlrev_b32 v112, 16, v12
    v_and_b32 v113, 4294901760, v12
    v_max_f32 v116, v112, v113
    s_nop 1
    v_max_f32_dpp v116, v116, v116 quad_perm:[1,0,3,2] row_mask:0xf bank_mask:0xf
    s_nop 1
    v_max_f32_dpp v116, v116, v116 quad_perm:[2,3,0,1] row_mask:0xf bank_mask:0xf
    v_mov_b32 v12, v116
    s_nop 1
    v_permlane16_swap_b32 v116, v12
    v_max_f32 v116, v116, v12
    v_mov_b32 v12, v116
    s_nop 1
    v_permlane32_swap_b32 v116, v12
    v_max_f32 v116, v116, v12
    v_mul_f32 v12, s37, v116
    v_fma_f32 v112, v112, s37, -v12
    v_fma_f32 v113, v113, s37, -v12
    v_exp_f32 v112, v112
    v_exp_f32 v113, v113
    s_nop 0
    v_cvt_pk_bf16_f32 v12, v112, v113
    v_add_f32 v117, v112, v113
    s_nop 0
    v_mov_b32_dpp v144, v12 quad_perm:[0,0,0,0] row_mask:0xf bank_mask:0xf
    v_mov_b32_dpp v145, v12 quad_perm:[1,1,1,1] row_mask:0xf bank_mask:0xf
    v_mov_b32_dpp v146, v12 quad_perm:[2,2,2,2] row_mask:0xf bank_mask:0xf
    v_mov_b32_dpp v147, v12 quad_perm:[3,3,3,3] row_mask:0xf bank_mask:0xf
    v_add_f32_dpp v117, v117, v117 quad_perm:[1,0,3,2] row_mask:0xf bank_mask:0xf
    s_nop 1
    v_add_f32_dpp v117, v117, v117 quad_perm:[2,3,0,1] row_mask:0xf bank_mask:0xf
    v_mov_b32 v12, v117
    s_nop 1
    v_permlane16_swap_b32 v117, v12
    v_add_f32 v117, v117, v12
    v_mov_b32 v12, v117
    s_nop 1
    v_permlane32_swap_b32 v117, v12
    v_add_f32 v117, v117, v12
    s_mov_b64 exec, 4369
    ds_write_b64 v161, v[116:117]
    s_mov_b64 exec, -1
    s_waitcnt vmcnt(8)
    v_perm_b32 v80, v52, v48, s34
    v_perm_b32 v84, v52, v48, s35
    v_perm_b32 v88, v53, v49, s34
    v_perm_b32 v92, v53, v49, s35
    v_perm_b32 v96, v54, v50, s34
    v_perm_b32 v100, v54, v50, s35
    v_perm_b32 v104, v55, v51, s34
    v_perm_b32 v108, v55, v51, s35
    s_waitcnt vmcnt(6)
    v_perm_b32 v81, v60, v56, s34
    v_perm_b32 v85, v60, v56, s35
    v_perm_b32 v89, v61, v57, s34
    v_perm_b32 v93, v61, v57, s35
    v_perm_b32 v97, v62, v58, s34
    v_perm_b32 v101, v62, v58, s35
    v_perm_b32 v105, v63, v59, s34
    v_perm_b32 v109, v63, v59, s35
    s_waitcnt vmcnt(4)
    v_perm_b32 v82, v68, v64, s34
    v_perm_b32 v86, v68, v64, s35
    v_perm_b32 v90, v69, v65, s34
    v_perm_b32 v94, v69, v65, s35
    v_perm_b32 v98, v70, v66, s34
    v_perm_b32 v102, v70, v66, s35
    v_perm_b32 v106, v71, v67, s34
    v_perm_b32 v110, v71, v67, s35
L_pdone:
    s_waitcnt vmcnt(2)
    s_cmp_lg_u32 s55, 0
    s_cbranch_scc1 L_noh1
    global_load_dwordx4 v[48:51], v154, s[22:23] offset:-3584 sc1
    global_load_dwordx4 v[52:55], v154, s[22:23] offset:3584 sc1
L_noh1:
    v_perm_b32 v83, v76, v72, s34
    v_perm_b32 v87, v76, v72, s35
    v_perm_b32 v91, v77, v73, s34
    v_perm_b32 v95, v77, v73, s35
    v_mfma_f32_16x16x32_bf16 v[112:115], v[144:147], v[80:83], 0
    v_mfma_f32_16x16x32_bf16 v[116:119], v[144:147], v[84:87], 0
    v_perm_b32 v99, v78, v74, s34
    v_perm_b32 v103, v78, v74, s35
    v_mfma_f32_16x16x32_bf16 v[120:123], v[144:147], v[88:91], 0
    v_mfma_f32_16x16x32_bf16 v[124:127], v[144:147], v[92:95], 0
    v_perm_b32 v107, v79, v75, s34
    v_perm_b32 v111, v79, v75, s35
    v_mfma_f32_16x16x32_bf16 v[128:131], v[144:147], v[96:99], 0
    v_mfma_f32_16x16x32_bf16 v[132:135], v[144:147], v[100:103], 0
    v_mfma_f32_16x16x32_bf16 v[136:139], v[144:147], v[104:107], 0
    v_mfma_f32_16x16x32_bf16 v[140:143], v[144:147], v[108:111], 0
    ds_write2st64_b32 v162, v112, v116 offset0:141 offset1:142
    s_nop 0
    ds_write2st64_b32 v162, v120, v124 offset0:143 offset1:144
    s_nop 2
    ds_write2st64_b32 v162, v128, v132 offset0:145 offset1:146
    s_nop 0
    ds_write2st64_b32 v162, v136, v140 offset0:147 offset1:148
    s_and_b32 s31, s31, 4
    s_cmp_eq_u32 s31, 0
    s_waitcnt lgkmcnt(0)
    s_barrier
    ds_read_b64 v[166:167], v11 offset:35584
    ds_read2st64_b32 v[80:81], v163 offset0:141 offset1:149
    ds_read2st64_b32 v[82:83], v163 offset0:157 offset1:165
    ds_read2st64_b32 v[84:85], v163 offset0:173 offset1:181
    ds_read2st64_b32 v[86:87], v163 offset0:189 offset1:197
    s_waitcnt lgkmcnt(4)
    v_max_f32_dpp v148, v166, v166 row_ror:4 row_mask:0xf bank_mask:0xf
    s_nop 1
    v_max_f32_dpp v148, v148, v148 row_ror:2 row_mask:0xf bank_mask:0xf
    s_nop 1
    v_max_f32_dpp v148, v148, v148 row_ror:1 row_mask:0xf bank_mask:0xf
    v_sub_f32 v166, v166, v148
    v_mul_f32 v166, s37, v166
    v_exp_f32 v166, v166
    s_waitcnt lgkmcnt(0)
    v_mul_f32 v167, v167, v166
    v_mul_f32_dpp v12, v166, v80 row_newbcast:0 row_mask:0xf bank_mask:0xf
    v_mul_f32_dpp v13, v166, v81 row_newbcast:1 row_mask:0xf bank_mask:0xf
    v_add_f32_dpp v167, v167, v167 row_ror:4 row_mask:0xf bank_mask:0xf
    v_fmac_f32_dpp v12, v166, v82 row_newbcast:2 row_mask:0xf bank_mask:0xf
    v_fmac_f32_dpp v13, v166, v83 row_newbcast:3 row_mask:0xf bank_mask:0xf
    v_add_f32_dpp v167, v167, v167 row_ror:2 row_mask:0xf bank_mask:0xf
    v_fmac_f32_dpp v12, v166, v84 row_newbcast:4 row_mask:0xf bank_mask:0xf
    v_fmac_f32_dpp v13, v166, v85 row_newbcast:5 row_mask:0xf bank_mask:0xf
    v_add_f32_dpp v167, v167, v167 row_ror:1 row_mask:0xf bank_mask:0xf
    v_fmac_f32_dpp v12, v166, v86 row_newbcast:6 row_mask:0xf bank_mask:0xf
    v_fmac_f32_dpp v13, v166, v87 row_newbcast:7 row_mask:0xf bank_mask:0xf
    v_cndmask_b32 v159, v148, v167, s[56:57]
    v_add_f32 v12, v12, v13
    v_bfi_b32 v159, s48, v149, v159
    v_bfi_b32 v158, s48, v149, v12
    s_cbranch_scc1 L_ost1
    global_store_dwordx2 v9, v[158:159], s[22:23] sc1
    s_branch L_ost2
L_ost1:
    global_store_dwordx2 v9, v[158:159], s[22:23]
L_ost2:
    s_waitcnt vmcnt(0)
    global_load_dwordx4 v[116:119], v10, s[22:23] sc1
    global_load_dwordx4 v[120:123], v10, s[22:23] offset:1024 sc1
    s_cmp_lg_u32 s55, 0
    s_cbranch_scc1 L_opoll_w
    s_waitcnt vmcnt(3)
L_hchk:
    v_xor_b32 v48, s54, v48
    v_xor_b32 v49, s54, v49
    v_xor_b32 v50, s54, v50
    v_xor_b32 v51, s54, v51
    v_xor_b32 v52, s54, v52
    v_xor_b32 v53, s54, v53
    v_xor_b32 v54, s54, v54
    v_xor_b32 v55, s54, v55
    v_or3_b32 v14, v48, v49, v50
    v_or3_b32 v15, v51, v52, v53
    v_or3_b32 v14, v14, v54, v55
    v_or_b32 v14, v14, v15
    v_and_b32 v14, s49, v14
    v_cmp_ne_u32 vcc, 0, v14
    s_cbranch_vccz L_hok
    s_mov_b64 exec, vcc
    global_load_dwordx4 v[48:51], v154, s[22:23] offset:-3584 sc1
    global_load_dwordx4 v[52:55], v154, s[22:23] offset:3584 sc1
    s_waitcnt vmcnt(0)
    s_sub_u32 s38, s38, 1
    s_cbranch_scc0 L_hchk
    s_branch L_end
L_hok:
    s_mov_b64 exec, -1
    v_add_f32_dpp v48, v48, v48 quad_perm:[1,0,3,2] row_mask:0xf bank_mask:0xf
    v_add_f32_dpp v49, v49, v49 quad_perm:[1,0,3,2] row_mask:0xf bank_mask:0xf
    v_add_f32_dpp v50, v50, v50 quad_perm:[1,0,3,2] row_mask:0xf bank_mask:0xf
    v_add_f32_dpp v51, v51, v51 quad_perm:[1,0,3,2] row_mask:0xf bank_mask:0xf
    v_add_f32_dpp v52, v52, v52 quad_perm:[1,0,3,2] row_mask:0xf bank_mask:0xf
    v_add_f32_dpp v53, v53, v53 quad_perm:[1,0,3,2] row_mask:0xf bank_mask:0xf
    v_add_f32_dpp v54, v54, v54 quad_perm:[1,0,3,2] row_mask:0xf bank_mask:0xf
    v_add_f32_dpp v55, v55, v55 quad_perm:[1,0,3,2] row_mask:0xf bank_mask:0xf
    v_add_f32_dpp v48, v48, v48 quad_perm:[2,3,0,1] row_mask:0xf bank_mask:0xf
    v_add_f32_dpp v49, v49, v49 quad_perm:[2,3,0,1] row_mask:0xf bank_mask:0xf
    v_add_f32_dpp v50, v50, v50 quad_perm:[2,3,0,1] row_mask:0xf bank_mask:0xf
    v_add_f32_dpp v51, v51, v51 quad_perm:[2,3,0,1] row_mask:0xf bank_mask:0xf
    v_add_f32_dpp v52, v52, v52 quad_perm:[2,3,0,1] row_mask:0xf bank_mask:0xf
    v_add_f32_dpp v53, v53, v53 quad_perm:[2,3,0,1] row_mask:0xf bank_mask:0xf
    v_add_f32_dpp v54, v54, v54 quad_perm:[2,3,0,1] row_mask:0xf bank_mask:0xf
    v_add_f32_dpp v55, v55, v55 quad_perm:[2,3,0,1] row_mask:0xf bank_mask:0xf
    v_cmp_gt_u32 vcc, 14, v156
    v_max_f32 v48, 0, v48
    v_max_f32 v49, 0, v49
    v_max_f32 v50, 0, v50
    v_max_f32 v51, 0, v51
    v_max_f32 v52, 0, v52
    v_max_f32 v53, 0, v53
    v_max_f32 v54, 0, v54
    v_max_f32 v55, 0, v55
    v_cvt_pk_bf16_f32 v48, v48, v49
    v_cvt_pk_bf16_f32 v49, v50, v51
    v_cvt_pk_bf16_f32 v50, v52, v53
    v_cvt_pk_bf16_f32 v51, v54, v55
    v_cndmask_b32 v48, 0, v48, vcc
    v_cndmask_b32 v49, 0, v49, vcc
    v_cndmask_b32 v50, 0, v50, vcc
    v_cndmask_b32 v51, 0, v51, vcc
    ds_write_b64 v157, v[48:49] offset:35072
    ds_write_b64 v157, v[50:51] offset:35200
L_ow:
    s_branch L_opoll_w
L_opoll:
    global_load_dwordx4 v[116:119], v10, s[22:23] sc1
    global_load_dwordx4 v[120:123], v10, s[22:23] offset:1024 sc1
L_opoll_w:
    s_waitcnt vmcnt(0)
    v_xor_b32 v116, s53, v116
    v_xor_b32 v117, s53, v117
    v_xor_b32 v118, s53, v118
    v_xor_b32 v119, s53, v119
    v_xor_b32 v120, s53, v120
    v_xor_b32 v121, s53, v121
    v_xor_b32 v122, s53, v122
    v_xor_b32 v123, s53, v123
    v_or3_b32 v14, v116, v117, v118
    v_or3_b32 v15, v119, v120, v121
    v_or3_b32 v14, v14, v122, v123
    v_or_b32 v14, v14, v15
    v_and_b32 v14, s48, v14
    v_cmp_ne_u32 vcc, 0, v14
    s_cbranch_vccz L_opoll_ok
    s_mov_b64 exec, vcc
    s_sub_u32 s38, s38, 1
    s_cbranch_scc0 L_opoll
    s_branch L_end
L_opoll_ok:
    s_mov_b64 exec, -1
    v_max_f32 v148, v117, v121
    s_nop 1
    v_max_f32_dpp v148, v148, v148 row_ror:8 row_mask:0xf bank_mask:0xf
    v_mov_b32 v12, v148
    s_nop 1
    v_permlane16_swap_b32 v148, v12
    v_max_f32 v148, v148, v12
    v_mov_b32 v12, v148
    s_nop 1
    v_permlane32_swap_b32 v148, v12
    v_max_f32 v148, v148, v12
    v_sub_f32 v81, v117, v148
    v_sub_f32 v85, v121, v148
    v_mul_f32 v81, s37, v81
    v_mul_f32 v85, s37, v85
    v_exp_f32 v81, v81
    v_exp_f32 v85, v85
    v_mul_f32 v83, v119, v81
    v_mul_f32 v80, v116, v81
    v_mul_f32 v82, v118, v81
    v_fmac_f32 v83, v123, v85
    v_fmac_f32 v80, v120, v85
    v_fmac_f32 v82, v122, v85
    v_add_f32_dpp v83, v83, v83 row_ror:8 row_mask:0xf bank_mask:0xf
    v_add_f32_dpp v80, v80, v80 row_ror:8 row_mask:0xf bank_mask:0xf
    v_add_f32_dpp v82, v82, v82 row_ror:8 row_mask:0xf bank_mask:0xf
    v_mov_b32 v12, v83
    s_nop 0
    v_permlane32_swap_b32 v80, v82
    v_permlane32_swap_b32 v83, v12
    v_add_f32 v80, v80, v82
    v_add_f32 v83, v83, v12
    v_mov_b32 v12, v83
    v_mov_b32 v13, v80
    s_nop 0
    v_permlane16_swap_b32 v83, v12
    v_permlane16_swap_b32 v80, v13
    v_add_f32 v83, v83, v12
    v_add_f32 v80, v80, v13
    v_rcp_f32 v83, v83
    s_mov_b32 exec_lo, 255
    s_mov_b32 exec_hi, 255
    v_mul_f32 v80, v80, v83
    v_cvt_pk_bf16_f32 v80, v80, v80
    ds_write_b16 v153, v80 offset:35328
    s_mov_b64 exec, -1
    s_cmp_lg_u32 s40, 0
    s_waitcnt lgkmcnt(0)
    s_barrier
    ds_read2_b64 v[32:35], v152 offset0:32 offset1:36
    ds_read_b64_tr_b16 v[16:17], v151 offset:0
    ds_read_b64_tr_b16 v[18:19], v151 offset:4096
    ds_read2_b64 v[36:39], v152 offset0:40 offset1:44
    ds_read_b64_tr_b16 v[20:21], v151 offset:8192
    ds_read_b64_tr_b16 v[22:23], v151 offset:12288
    s_cbranch_scc0 L_ffn
    s_waitcnt lgkmcnt(3)
    v_mfma_f32_16x16x32_bf16 v[84:87], v[32:35], v[16:19], 0
    s_waitcnt lgkmcnt(0)
    v_mfma_f32_16x16x32_bf16 v[84:87], v[36:39], v[20:23], v[84:87]
    s_branch L_noffn
L_ffn:
    ds_read2_b64 v[40:43], v152 offset0:0 offset1:4
    ds_read_b64_tr_b16 v[24:25], v151 offset:16384
    ds_read_b64_tr_b16 v[26:27], v151 offset:20480
    ds_read2_b64 v[44:47], v152 offset0:8 offset1:12
    ds_read_b64_tr_b16 v[28:29], v151 offset:24576
    ds_read_b64_tr_b16 v[30:31], v151 offset:28672
    s_waitcnt lgkmcnt(9)
    v_mfma_f32_16x16x32_bf16 v[84:87], v[32:35], v[16:19], 0
    s_waitcnt lgkmcnt(6)
    v_mfma_f32_16x16x32_bf16 v[84:87], v[36:39], v[20:23], v[84:87]
    s_waitcnt lgkmcnt(3)
    v_mfma_f32_16x16x32_bf16 v[84:87], v[40:43], v[24:27], v[84:87]
    s_waitcnt lgkmcnt(0)
    v_mfma_f32_16x16x32_bf16 v[84:87], v[44:47], v[28:31], v[84:87]
L_noffn:
    s_mov_b32 exec_hi, 0
    s_cmp_lg_u32 s28, 0
    s_nop 5
    v_bfi_b32 v88, s48, v149, v84
    global_store_dword v150, v88, s[22:23] sc1
    s_cbranch_scc1 L_fin
    s_mov_b64 exec, -1
    s_waitcnt vmcnt(0)
    global_load_dwordx2 v[104:105], v155, s[4:5]
    s_waitcnt vmcnt(0)
    v_lshlrev_b32 v106, 16, v104
    v_and_b32 v107, 4294901760, v104
    v_lshlrev_b32 v108, 16, v105
    v_and_b32 v109, 4294901760, v105
L_fpoll:
    global_load_dwordx4 v[16:19], v164, s[22:23] offset:-4096 sc1
    global_load_dwordx4 v[20:23], v164, s[22:23] offset:-2048 sc1
    global_load_dwordx4 v[24:27], v164, s[22:23] offset:0 sc1
    global_load_dwordx4 v[28:31], v164, s[22:23] offset:2048 sc1
L_fpoll_w:
    s_waitcnt vmcnt(0)
    v_xor_b32 v16, s53, v16
    v_xor_b32 v17, s53, v17
    v_xor_b32 v18, s53, v18
    v_xor_b32 v19, s53, v19
    v_xor_b32 v20, s53, v20
    v_xor_b32 v21, s53, v21
    v_xor_b32 v22, s53, v22
    v_xor_b32 v23, s53, v23
    v_xor_b32 v24, s53, v24
    v_xor_b32 v25, s53, v25
    v_xor_b32 v26, s53, v26
    v_xor_b32 v27, s53, v27
    v_xor_b32 v28, s53, v28
    v_xor_b32 v29, s53, v29
    v_xor_b32 v30, s53, v30
    v_xor_b32 v31, s53, v31
    v_or3_b32 v14, v16, v17, v18
    v_or3_b32 v15, v19, v20, v21
    v_or3_b32 v14, v14, v22, v23
    v_or3_b32 v15, v15, v24, v25
    v_or3_b32 v14, v14, v26, v27
    v_or3_b32 v15, v15, v28, v29
    v_or3_b32 v14, v14, v30, v31
    v_or_b32 v14, v14, v15
    v_and_b32 v14, s48, v14
    v_cmp_ne_u32 vcc, 0, v14
    s_cbranch_vccz L_fpoll_ok
    s_mov_b64 exec, vcc
    s_sub_u32 s38, s38, 1
    s_cbranch_scc0 L_fpoll
    s_branch L_end
L_fpoll_ok:
    s_mov_b64 exec, -1
    v_add_f32 v88, v16, v20
    v_add_f32 v96, v24, v28
    v_add_f32 v89, v17, v21
    v_add_f32 v97, v25, v29
    v_add_f32 v90, v18, v22
    v_add_f32 v98, v26, v30
    v_add_f32 v91, v19, v23
    v_add_f32 v99, v27, v31
    v_add_f32 v88, v88, v96
    v_add_f32 v89, v89, v97
    v_add_f32 v90, v90, v98
    v_add_f32 v91, v91, v99
    v_add_f32_dpp v88, v88, v88 row_ror:8 row_mask:0xf bank_mask:0xf
    v_add_f32_dpp v89, v89, v89 row_ror:8 row_mask:0xf bank_mask:0xf
    v_add_f32_dpp v90, v90, v90 row_ror:8 row_mask:0xf bank_mask:0xf
    v_add_f32_dpp v91, v91, v91 row_ror:8 row_mask:0xf bank_mask:0xf
    v_add_f32_dpp v88, v88, v88 row_ror:4 row_mask:0xf bank_mask:0xf
    v_add_f32_dpp v89, v89, v89 row_ror:4 row_mask:0xf bank_mask:0xf
    v_add_f32_dpp v90, v90, v90 row_ror:4 row_mask:0xf bank_mask:0xf
    v_add_f32_dpp v91, v91, v91 row_ror:4 row_mask:0xf bank_mask:0xf
    v_add_f32_dpp v88, v88, v88 row_ror:2 row_mask:0xf bank_mask:0xf
    v_add_f32_dpp v89, v89, v89 row_ror:2 row_mask:0xf bank_mask:0xf
    v_add_f32_dpp v90, v90, v90 row_ror:2 row_mask:0xf bank_mask:0xf
    v_add_f32_dpp v91, v91, v91 row_ror:2 row_mask:0xf bank_mask:0xf
    v_add_f32_dpp v88, v88, v88 row_ror:1 row_mask:0xf bank_mask:0xf
    v_add_f32_dpp v89, v89, v89 row_ror:1 row_mask:0xf bank_mask:0xf
    v_add_f32_dpp v90, v90, v90 row_ror:1 row_mask:0xf bank_mask:0xf
    v_add_f32_dpp v91, v91, v91 row_ror:1 row_mask:0xf bank_mask:0xf
    v_add_f32 v88, v88, v106
    v_add_f32 v89, v89, v107
    v_add_f32 v90, v90, v108
    v_add_f32 v91, v91, v109
    v_cvt_pk_bf16_f32 v88, v88, v89
    v_cvt_pk_bf16_f32 v89, v90, v91
    s_mov_b32 exec_lo, 65537
    s_mov_b32 exec_hi, 65537
    global_store_dwordx2 v155, v[88:89], s[20:21]
    s_or_b32 s41, s2, s24
    s_cbranch_scc1 L_fin
    s_mov_b64 exec, 1
    v_mov_b32 v12, 0
    global_store_dword v12, v149, s[22:23]
L_fin:
    s_endpgm
L_end:
    s_endpgm
.section .rodata,"a"
.p2align 6
.amdhsa_kernel parallel_sum__sliding_block_cached__dense_activation_relu__decode_kernel
  .amdhsa_next_free_vgpr 168
  .amdhsa_next_free_sgpr 72
  .amdhsa_accum_offset 168
  .amdhsa_group_segment_fixed_size 0
  .amdhsa_kernarg_size 88
  .amdhsa_user_sgpr_count 2
  .amdhsa_user_sgpr_kernarg_segment_ptr 1
  .amdhsa_system_sgpr_workgroup_id_x 1
.end_amdhsa_kernel
```
